```python
import torch

def _softmax(x, axis=-1):
    return torch.softmax(x, dim=axis)
def _gelu(x):
    return torch.nn.functional.gelu(x, approximate="tanh")
def _silu(x):
    return torch.nn.functional.silu(x)
def _sigmoid(x):
    return torch.sigmoid(x)
def _layernorm(x, axis=-1, eps=1e-5):
    m = x.mean(dim=axis, keepdim=True)
    v = x.var(dim=axis, keepdim=True, unbiased=False)
    return (x - m) / torch.sqrt(v + eps)
def _scatter_add(tgt, idx, src, axis=0):
    return tgt.clone().index_add_(axis, idx, src)
def _segment_sum(src, seg, n):
    out = torch.zeros((n,) + src.shape[1:], dtype=src.dtype)
    return out.index_add_(0, seg, src)
def _pad(x, pw):
    flat = tuple(v for pair in reversed(pw) for v in pair)
    return torch.nn.functional.pad(x, flat)

kernel_name = 'concat_heads__sliding_block_cached__sliding_block_cached__decode'

def setup_inputs():

    _w = (lambda a: (lambda t: t.to(torch.bfloat16) if t.is_floating_point() else t)(torch.as_tensor(a)))
    def _A_setup():
        B, Sq, D = 2, 1, 576
        Hq, Hkv, Sk, Dh = 32, 16, 8192, 128
        assert Hq % Hkv == 0, (Hq, Hkv)
        return {
            "x": _w((lambda *s: torch.randn(*s, dtype=torch.bfloat16) * 0.8)(B, Sq, D)),
            "k_cache": _w((lambda *s: torch.randn(*s, dtype=torch.bfloat16) * 0.8)(B, Hkv, Sk, Dh)),
            "v_cache": _w((lambda *s: torch.randn(*s, dtype=torch.bfloat16) * 0.05)(B, Hkv, Sk, Dh)),
            "wq": _w((lambda *s: torch.randn(*s, dtype=torch.bfloat16) * 0.8)(D, Hq * Dh) * (D ** -0.5)),
            "wo": _w((lambda *s: torch.randn(*s, dtype=torch.bfloat16) * 0.05)(Hq * Dh, D) * ((Hq * Dh) ** -0.5)),
        }
    _A_in = _A_setup()

    def _B_setup():
        B, Sq, D = 2, 1, 576
        Hq, Hkv, Sk, Dh = 32, 16, 8192, 128
        assert Hq % Hkv == 0, (Hq, Hkv)
        return {
            "x": _w((lambda *s: torch.randn(*s, dtype=torch.bfloat16) * 0.8)(B, Sq, D)),
            "k_cache": _w((lambda *s: torch.randn(*s, dtype=torch.bfloat16) * 0.8)(B, Hkv, Sk, Dh)),
            "v_cache": _w((lambda *s: torch.randn(*s, dtype=torch.bfloat16) * 0.05)(B, Hkv, Sk, Dh)),
            "wq": _w((lambda *s: torch.randn(*s, dtype=torch.bfloat16) * 0.8)(D, Hq * Dh) * (D ** -0.5)),
            "wo": _w((lambda *s: torch.randn(*s, dtype=torch.bfloat16) * 0.05)(Hq * Dh, D) * ((Hq * Dh) ** -0.5)),
        }
    _B_in = _B_setup()

    return {
        "A_x": _A_in["x"],
        "A_k_cache": _A_in["k_cache"],
        "A_v_cache": _A_in["v_cache"],
        "A_wq": _A_in["wq"],
        "A_wo": _A_in["wo"],
        "B_x": _B_in["x"],
        "B_k_cache": _B_in["k_cache"],
        "B_v_cache": _B_in["v_cache"],
        "B_wq": _B_in["wq"],
        "B_wo": _B_in["wo"],
    }

def reference(A_x, A_k_cache, A_v_cache, A_wq, A_wo, B_x, B_k_cache, B_v_cache, B_wq, B_wo):
    def _A_ref(x, k_cache, v_cache, wq, wo):
        B, Sq, D = x.shape
        Hq, Dh = 32, 128
        Hkv, Sk = k_cache.shape[1], k_cache.shape[2]
        W = min(4096, max(256, Sk // 4))
        rep = Hq // Hkv
        q = (lambda x, *d: x.permute(*d))((x @ wq).reshape(B, Sq, Hq, Dh), 0, 2, 1, 3)
        k = (lambda x, n, axis: torch.repeat_interleave(x, n, dim=axis))(k_cache[:, :, Sk - W:, :], rep, axis=1)
        v = (lambda x, n, axis: torch.repeat_interleave(x, n, dim=axis))(v_cache[:, :, Sk - W:, :], rep, axis=1)
        scores = torch.einsum("bhqd,bhkd->bhqk", q, k) * (Dh ** -0.5)
        p = _softmax(scores, axis=-1)
        o = torch.einsum("bhqk,bhkd->bhqd", p, v)
        return (lambda x, *d: x.permute(*d))(o, 0, 2, 1, 3).reshape(B, Sq, Hq * Dh) @ wo

    def _B_ref(x, k_cache, v_cache, wq, wo):
        B, Sq, D = x.shape
        Hq, Dh = 32, 128
        Hkv, Sk = k_cache.shape[1], k_cache.shape[2]
        W = min(4096, max(256, Sk // 4))
        rep = Hq // Hkv
        q = (lambda x, *d: x.permute(*d))((x @ wq).reshape(B, Sq, Hq, Dh), 0, 2, 1, 3)
        k = (lambda x, n, axis: torch.repeat_interleave(x, n, dim=axis))(k_cache[:, :, Sk - W:, :], rep, axis=1)
        v = (lambda x, n, axis: torch.repeat_interleave(x, n, dim=axis))(v_cache[:, :, Sk - W:, :], rep, axis=1)
        scores = torch.einsum("bhqd,bhkd->bhqk", q, k) * (Dh ** -0.5)
        p = _softmax(scores, axis=-1)
        o = torch.einsum("bhqk,bhkd->bhqd", p, v)
        return (lambda x, *d: x.permute(*d))(o, 0, 2, 1, 3).reshape(B, Sq, Hq * Dh) @ wo

    a = _A_ref(A_x, A_k_cache, A_v_cache, A_wq, A_wo)
    b = _B_ref(B_x, B_k_cache, B_v_cache, B_wq, B_wo)
    return torch.concatenate([a, b], axis=-1)
```

```asm
; @launch grid=(256,1,1) block=(512,1,1) lds=57344
.amdgcn_target "amdgcn-amd-amdhsa--gfx950"
.text
.globl concat_heads__sliding_block_cached__sliding_block_cached__decode_kernel
.p2align 8
.type concat_heads__sliding_block_cached__sliding_block_cached__decode_kernel,@function
concat_heads__sliding_block_cached__sliding_block_cached__decode_kernel:
L_begin:
    s_cmp_ge_u32 s2, 256
    s_cbranch_scc1 L_end
    s_bfe_u32 s4, s2, 0x10004
    s_mul_i32 s5, s4, 40
    s_load_dwordx2 s[36:37], s[0:1], s5 offset:24
    s_load_dwordx2 s[24:25], s[0:1], s5
    s_load_dwordx2 s[28:29], s[0:1], s5 offset:8
    s_load_dwordx2 s[32:33], s[0:1], s5 offset:16
    s_load_dwordx2 s[40:41], s[0:1], s5 offset:32
    s_load_dwordx2 s[44:45], s[0:1], 96
    s_load_dwordx2 s[48:49], s[0:1], 80
    v_lshrrev_b32 v36, 6, v0
    v_and_b32 v0, 63, v0
    v_readfirstlane_b32 s3, v36
    s_lshr_b32 s6, s2, 5
    s_and_b32 s7, s2, 15
    s_and_b32 s8, s2, 31
    s_mov_b32 s26, 0x900
    s_mov_b32 s27, 0x20000
    s_mov_b32 s38, 0x480000
    s_mov_b32 s39, 0x20000
    s_mov_b32 s30, 0x4000000
    s_mov_b32 s31, 0x20000
    s_mov_b32 s34, 0x4000000
    s_mov_b32 s35, 0x20000
    s_mov_b32 s42, 0x480000
    s_mov_b32 s43, 0x20000
    s_mov_b32 s46, 0x11201200
    s_mov_b32 s47, 0x20000
    s_mov_b32 s50, 0x1200
    s_mov_b32 s51, 0x20000
    v_lshrrev_b32 v36, 4, v0
    v_and_b32 v37, 15, v0
    v_bfe_u32 v38, v0, 2, 2
    v_bfe_u32 v39, v0, 1, 1
    v_and_b32 v40, 1, v0
    s_and_b32 s9, s6, 3
    s_mul_i32 s10, s9, 144
    s_lshl_b32 s11, s3, 2
    s_add_u32 s10, s10, s11
    s_lshr_b32 s11, s6, 2
    s_lshl_b32 s12, s7, 1
    s_add_u32 s12, s12, s11
    s_lshl_b32 s12, s12, 8
    v_add_u32 v41, s10, v36
    v_lshlrev_b32 v41, 13, v41
    v_lshl_add_u32 v41, v37, 4, v41
    v_add_u32 v3, s12, v41
    s_lshl_b32 s12, s3, 14
    s_sub_u32 s12, 0x100000, s12
    v_add_u32 v4, s12, v3
    v_mul_u32_u24 v41, 576, v39
    v_add3_u32 v41, v41, v36, s10
    v_lshl_add_u32 v42, v38, 5, v41
    v_lshlrev_b32 v6, 1, v42
    s_lshl_b32 s12, s3, 1
    s_sub_u32 s12, 128, s12
    v_add_lshl_u32 v11, v41, s12, 1
    v_mov_b32 v13, 0
    v_mov_b32 v144, 0
    v_mov_b32 v145, 0
    v_mov_b32 v146, 0
    v_mov_b32 v147, 0
    s_waitcnt lgkmcnt(0)
    buffer_load_dwordx4 v[128:131], v3, s[36:39], 0 offen nt
    buffer_load_ushort v12, v6, s[24:27], 0 offen
    s_mov_b32 exec_hi, 0
    buffer_load_ushort v13, v11, s[24:27], 0 offen
    s_mov_b32 exec_hi, -1
    s_mov_b32 s20, 0x40000
    buffer_load_dwordx4 v[132:135], v3, s[36:39], s20 offen nt
    s_mov_b32 s20, 0x80000
    buffer_load_dwordx4 v[136:139], v3, s[36:39], s20 offen nt
    s_mov_b32 s20, 0xc0000
    buffer_load_dwordx4 v[140:143], v3, s[36:39], s20 offen nt
    s_mov_b32 exec_hi, 0
    buffer_load_dwordx4 v[144:147], v4, s[36:39], 0 offen nt
    s_mov_b32 exec_hi, -1
    s_lshl_b32 s12, s4, 8
    s_load_dword s13, s[44:45], s12
    s_lshl_b32 s12, s11, 4
    s_add_u32 s12, s12, s7
    s_lshl_b32 s12, s12, 21
    s_lshl_b32 s9, s9, 17
    s_add_u32 s12, s12, s9
    s_add_u32 s12, s12, 0x180000
    s_mul_i32 s9, s6, 4
    s_add_u32 s9, s9, s3
    s_add_u32 s21, s9, 0
    s_and_b32 s21, s21, 31
    s_lshl_b32 s21, s21, 12
    s_add_u32 s23, s9, 8
    s_and_b32 s23, s23, 31
    s_lshl_b32 s23, s23, 12
    s_add_u32 s56, s9, 16
    s_and_b32 s56, s56, 31
    s_lshl_b32 s56, s56, 12
    s_add_u32 s57, s9, 24
    s_and_b32 s57, s57, 31
    s_lshl_b32 s57, s57, 12
    v_lshlrev_b32 v15, 4, v0
    v_add_u32 v2, s12, v15
    v_and_b32 v41, 3, v0
    v_lshlrev_b32 v41, 4, v41
    v_lshl_add_u32 v41, v36, 6, v41
    v_lshl_add_u32 v41, v38, 8, v41
    v_add_u32 v1, s12, v41
    buffer_load_dwordx4 v[64:67], v1, s[28:31], s21 offen offset:0 nt
    v_mov_b32 v54, 0
    s_cmp_lg_u32 s3, 0
    s_cbranch_scc1 L_noinit
    ds_write_b32 v54, v54 offset:18048
    ds_write_b32 v54, v54 offset:18064
    ds_write_b32 v54, v54 offset:18052
L_noinit:
    s_mov_b32 s16, 0xfffff000
    s_mov_b32 s17, 0x3e0293ee
    v_lshlrev_b32 v7, 4, v40
    v_mov_b32 v8, 0xffff
    v_lshlrev_b32 v8, v7, v8
    v_mov_b32 v16, 0
    v_mov_b32 v17, 0
    v_mov_b32 v18, 0
    v_mov_b32 v19, 0
    v_mov_b32 v20, 0
    v_mov_b32 v21, 0
    v_mov_b32 v22, 0
    v_mov_b32 v23, 0
    s_lshl_b32 s9, s8, 13
    s_add_u32 s9, s9, 0x10000
    s_lshl_b32 s10, s6, 10
    s_add_u32 s10, s10, s9
    v_lshlrev_b32 v41, 3, v36
    v_lshl_add_u32 v41, v38, 1, v41
    v_add_u32 v41, v41, v40
    v_lshlrev_b32 v41, 4, v41
    v_lshl_add_u32 v41, v39, 9, v41
    v_add_u32 v10, s10, v41
    s_lshr_b32 s10, s6, 2
    s_lshl_b32 s10, s10, 9
    s_add_u32 s10, s10, s9
    v_lshrrev_b32 v41, 5, v0
    v_lshlrev_b32 v42, 12, v41
    v_and_b32 v9, 31, v0
    v_lshl_add_u32 v42, v9, 4, v42
    v_add_u32 v9, s10, v42
    v_lshlrev_b32 v41, 8, v41
    v_bfe_u32 v42, v0, 3, 2
    v_lshl_add_u32 v41, v42, 6, v41
    v_and_b32 v42, 7, v0
    v_lshl_add_u32 v61, v42, 1, v41
    v_lshlrev_b32 v41, 8, v39
    v_lshrrev_b32 v42, 2, v0
    v_lshl_add_u32 v62, v42, 4, v41
    v_lshlrev_b32 v63, 5, v39
    s_lshl_b32 s9, s3, 2
    v_add_u32 v244, s9, v63
    s_lshl_b32 s19, s7, 3
    s_add_u32 s19, s19, s6
    s_mul_i32 s9, s19, 36864
    s_lshl_b32 s10, s3, 12
    s_add_u32 s10, s10, s9
    v_add_u32 v5, s10, v15
    s_lshl_b32 s10, s3, 10
    v_add_u32 v60, s10, v15
    s_and_b32 s22, s3, 1
    v_lshlrev_b32 v41, 4, v36
    v_lshl_add_u32 v41, v40, 3, v41
    v_bfe_u32 v42, v0, 3, 1
    v_lshl_add_u32 v41, v42, 2, v41
    v_bfe_u32 v42, v0, 2, 1
    v_add_u32 v41, v41, v42
    s_lshl_b32 s10, s22, 1
    v_add_u32 v41, s10, v41
    v_lshlrev_b32 v41, 4, v41
    v_lshl_add_u32 v245, v39, 3, v41
    s_lshl_b32 s10, s22, 5
    v_mov_b32 v247, s10
    s_lshl_b32 s9, s8, 14
    s_add_u32 s9, s9, 0x50000
    s_lshl_b32 s10, s6, 11
    s_add_u32 s10, s10, s9
    s_lshl_b32 s11, s22, 10
    s_add_u32 s10, s10, s11
    v_add_u32 v246, s10, v15
    s_lshl_b32 s10, s6, 8
    s_add_u32 s10, s10, s9
    v_lshl_add_u32 v41, v39, 2, v40
    v_lshlrev_b32 v41, 11, v41
    v_lshrrev_b32 v42, 2, v0
    v_lshl_add_u32 v41, v42, 4, v41
    v_add_u32 v248, s10, v41
    v_lshlrev_b32 v249, 3, v0
    v_lshrrev_b32 v41, 1, v0
    v_lshlrev_b32 v41, 11, v41
    v_lshl_add_u32 v41, v40, 7, v41
    v_add_u32 v41, s10, v41
    v_mov_b32 v11, v41
    s_mul_i32 s11, s4, 589824
    s_add_u32 s11, s11, 0xd0000
    s_lshl_b32 s9, s19, 6
    s_add_u32 s9, s9, s11
    s_lshl_b32 s10, s3, 4
    v_lshrrev_b32 v41, 2, v0
    v_add_u32 v41, s10, v41
    v_lshlrev_b32 v41, 13, v41
    v_and_b32 v42, 3, v0
    v_lshl_add_u32 v41, v42, 4, v41
    v_add_u32 v250, s9, v41
    s_lshl_b32 s18, s6, 4
    s_add_u32 s18, s18, s7
    s_lshl_b32 s9, s18, 13
    s_add_u32 s9, s9, s11
    v_add_u32 v251, s9, v60
    v_and_b32 v42, 3, v0
    v_lshl_add_u32 v42, v36, 2, v42
    v_lshlrev_b32 v42, 2, v42
    s_lshl_b32 s10, s3, 6
    v_add_u32 v252, s10, v42
    v_lshl_add_u32 v253, v38, 6, v42
    s_lshr_b32 s9, s18, 4
    s_lshl_b32 s9, s9, 7
    s_bfe_u32 s10, s18, 0x20002
    s_lshl_b32 s10, s10, 5
    s_add_u32 s9, s9, s10
    s_and_b32 s10, s18, 3
    s_lshl_b32 s10, s10, 1
    s_add_u32 s9, s9, s10
    s_mul_i32 s10, s4, 576
    s_add_u32 s9, s9, s10
    v_bfe_u32 v41, v0, 4, 1
    v_lshlrev_b32 v41, 4, v41
    v_lshrrev_b32 v42, 5, v0
    v_lshl_add_u32 v41, v42, 3, v41
    v_mul_u32_u24 v42, 1152, v39
    v_add3_u32 v41, v41, v42, v40
    v_add_u32 v41, s9, v41
    v_lshlrev_b32 v41, 1, v41
    v_mov_b32 v254, v41
    s_lshl_b32 s9, s4, 8
    v_mov_b32 v255, s9
    v_mul_u32_u24 v41, 1152, v36
    v_lshl_add_u32 v41, v37, 4, v41
    s_lshl_b32 s10, s3, 8
    v_add_u32 v59, s10, v41
    s_getreg_b32 s12, hwreg(HW_REG_XCC_ID, 0, 3)
    s_waitcnt lgkmcnt(0)
    s_add_u32 s14, s13, 1
    s_and_b32 s14, s14, 0xfff
    v_mov_b32 v14, s14
    s_and_b32 s9, s14, 0x1ff
    s_lshl_b32 s12, s12, 9
    s_or_b32 s9, s9, s12
    v_mov_b32 v55, s9
    s_barrier
    s_waitcnt vmcnt(5)
    v_lshlrev_b32 v12, v7, v12
    v_lshlrev_b32 v13, v7, v13
    s_nop 0
    v_mov_b32_dpp v16, v12 quad_perm:[0,1,2,3] row_mask:0xf bank_mask:0x1
    v_mov_b32_dpp v17, v12 row_ror:4 row_mask:0xf bank_mask:0x2
    v_mov_b32_dpp v18, v12 row_ror:8 row_mask:0xf bank_mask:0x4
    v_mov_b32_dpp v19, v12 row_ror:12 row_mask:0xf bank_mask:0x8
    v_mov_b32_dpp v20, v12 row_ror:12 row_mask:0xf bank_mask:0x1
    v_mov_b32_dpp v21, v12 quad_perm:[0,1,2,3] row_mask:0xf bank_mask:0x2
    v_mov_b32_dpp v22, v12 row_ror:4 row_mask:0xf bank_mask:0x4
    v_mov_b32_dpp v23, v12 row_ror:8 row_mask:0xf bank_mask:0x8
    v_mfma_f32_16x16x32_bf16 v[24:27], v[128:131], v[16:19], 0
    v_mov_b32_dpp v16, v12 row_ror:8 row_mask:0xf bank_mask:0x1
    v_mov_b32_dpp v17, v12 row_ror:12 row_mask:0xf bank_mask:0x2
    v_mov_b32_dpp v18, v12 quad_perm:[0,1,2,3] row_mask:0xf bank_mask:0x4
    v_mov_b32_dpp v19, v12 row_ror:4 row_mask:0xf bank_mask:0x8
    s_waitcnt vmcnt(4)
    v_mfma_f32_16x16x32_bf16 v[24:27], v[132:135], v[20:23], v[24:27]
    v_mov_b32_dpp v20, v12 row_ror:4 row_mask:0xf bank_mask:0x1
    v_mov_b32_dpp v21, v12 row_ror:8 row_mask:0xf bank_mask:0x2
    v_mov_b32_dpp v22, v12 row_ror:12 row_mask:0xf bank_mask:0x4
    v_mov_b32_dpp v23, v12 quad_perm:[0,1,2,3] row_mask:0xf bank_mask:0x8
    s_waitcnt vmcnt(3)
    buffer_load_dwordx4 v[68:71], v1, s[28:31], s21 offen offset:1024 nt
    v_mfma_f32_16x16x32_bf16 v[24:27], v[136:139], v[16:19], v[24:27]
    v_mov_b32_dpp v16, v13 quad_perm:[0,1,2,3] row_mask:0xf bank_mask:0x1
    v_mov_b32_dpp v17, v13 row_ror:4 row_mask:0xf bank_mask:0x2
    v_mov_b32_dpp v18, v13 row_ror:8 row_mask:0xf bank_mask:0x4
    v_mov_b32_dpp v19, v13 row_ror:12 row_mask:0xf bank_mask:0x8
    s_waitcnt vmcnt(3)
    buffer_load_dwordx4 v[72:75], v1, s[28:31], s21 offen offset:2048 nt
    v_mfma_f32_16x16x32_bf16 v[24:27], v[140:143], v[20:23], v[24:27]
    s_waitcnt vmcnt(3)
    buffer_load_dwordx4 v[76:79], v1, s[28:31], s21 offen offset:3072 nt
    v_mfma_f32_16x16x32_bf16 v[24:27], v[144:147], v[16:19], v[24:27]
    v_mov_b32 v4, v59
    s_mul_i32 s9, s19, 36864
    s_lshl_b32 s10, s3, 9
    s_add_u32 s9, s9, s10
    s_add_u32 s9, s9, 32768
    s_add_u32 s25, s10, 52224
    v_add_u32 v3, s9, v15
    s_lshl_b32 s24, s3, 12
    s_add_u32 s24, s24, 19456
    ds_write_b128 v60, v[24:27] offset:0
    s_waitcnt lgkmcnt(0)
    v_mov_b32 v36, 1
    s_mov_b64 exec, 1
    ds_add_rtn_u32 v37, v54, v36 offset:18048
    s_mov_b64 exec, -1
    s_waitcnt lgkmcnt(0)
    v_readfirstlane_b32 s9, v37
    s_cmp_eq_u32 s9, 7
    s_cbranch_scc0 L_noqred
    ds_read_b128 v[208:211], v15 offset:0
    ds_read_b128 v[212:215], v15 offset:1024
    ds_read_b128 v[216:219], v15 offset:2048
    ds_read_b128 v[220:223], v15 offset:3072
    ds_read_b128 v[224:227], v15 offset:4096
    ds_read_b128 v[228:231], v15 offset:5120
    ds_read_b128 v[232:235], v15 offset:6144
    ds_read_b128 v[236:239], v15 offset:7168
    s_waitcnt lgkmcnt(0)
    v_pk_add_f32 v[208:209], v[208:209], v[212:213]
    v_pk_add_f32 v[210:211], v[210:211], v[214:215]
    v_pk_add_f32 v[216:217], v[216:217], v[220:221]
    v_pk_add_f32 v[218:219], v[218:219], v[222:223]
    v_pk_add_f32 v[224:225], v[224:225], v[228:229]
    v_pk_add_f32 v[226:227], v[226:227], v[230:231]
    v_pk_add_f32 v[232:233], v[232:233], v[236:237]
    v_pk_add_f32 v[234:235], v[234:235], v[238:239]
    v_pk_add_f32 v[208:209], v[208:209], v[216:217]
    v_pk_add_f32 v[210:211], v[210:211], v[218:219]
    v_pk_add_f32 v[224:225], v[224:225], v[232:233]
    v_pk_add_f32 v[226:227], v[226:227], v[234:235]
    v_pk_add_f32 v[208:209], v[208:209], v[224:225]
    v_pk_add_f32 v[210:211], v[210:211], v[226:227]
    v_and_or_b32 v208, v208, s16, v55
    v_and_or_b32 v209, v209, s16, v55
    v_and_or_b32 v210, v210, s16, v55
    v_and_or_b32 v211, v211, s16, v55
    buffer_store_dwordx4 v[208:211], v10, s[44:47], 0 offen
    ds_write_b128 v15, v[208:211] offset:18432
    s_waitcnt lgkmcnt(0)
    v_mov_b32 v36, 9
    ds_write_b32 v54, v36 offset:18052
L_noqred:
    s_waitcnt vmcnt(3)
    buffer_load_dwordx4 v[80:83], v1, s[28:31], s23 offen offset:0 nt
    s_waitcnt vmcnt(3)
    buffer_load_dwordx4 v[84:87], v1, s[28:31], s23 offen offset:1024 nt
    s_waitcnt vmcnt(3)
    buffer_load_dwordx4 v[88:91], v1, s[28:31], s23 offen offset:2048 nt
    s_waitcnt vmcnt(3)
    buffer_load_dwordx4 v[92:95], v1, s[28:31], s23 offen offset:3072 nt
    s_waitcnt vmcnt(3)
    buffer_load_dwordx4 v[96:99], v1, s[28:31], s56 offen offset:0 nt
    s_waitcnt vmcnt(3)
    buffer_load_dwordx4 v[100:103], v1, s[28:31], s56 offen offset:1024 nt
    s_waitcnt vmcnt(3)
    buffer_load_dwordx4 v[104:107], v1, s[28:31], s56 offen offset:2048 nt
    s_cmp_lg_u32 s3, 0
    s_cbranch_scc1 L_kplain
    buffer_load_dwordx4 v[192:195], v9, s[44:47], 0 offen offset:0 nt
    buffer_load_dwordx4 v[196:199], v9, s[44:47], 0 offen offset:1024 nt
    buffer_load_dwordx4 v[200:203], v9, s[44:47], 0 offen offset:2048 nt
    buffer_load_dwordx4 v[204:207], v9, s[44:47], 0 offen offset:3072 nt
    s_waitcnt vmcnt(7)
    buffer_load_dwordx4 v[108:111], v1, s[28:31], s56 offen offset:3072 nt
    s_waitcnt vmcnt(7)
    buffer_load_dwordx4 v[112:115], v1, s[28:31], s57 offen offset:0 nt
    s_waitcnt vmcnt(7)
    buffer_load_dwordx4 v[116:119], v1, s[28:31], s57 offen offset:1024 nt
    s_waitcnt vmcnt(7)
    buffer_load_dwordx4 v[120:123], v1, s[28:31], s57 offen offset:2048 nt
    s_waitcnt vmcnt(3)
    buffer_load_dwordx4 v[124:127], v1, s[28:31], s57 offen offset:3072 nt
    s_mov_b32 s15, 200000
    s_mov_b32 s27, 0
L_qchk:
    v_xor_b32 v192, v55, v192
    v_xor_b32 v193, v55, v193
    v_xor_b32 v194, v55, v194
    v_xor_b32 v195, v55, v195
    v_xor_b32 v196, v55, v196
    v_xor_b32 v197, v55, v197
    v_xor_b32 v198, v55, v198
    v_xor_b32 v199, v55, v199
    v_xor_b32 v200, v55, v200
    v_xor_b32 v201, v55, v201
    v_xor_b32 v202, v55, v202
    v_xor_b32 v203, v55, v203
    v_xor_b32 v204, v55, v204
    v_xor_b32 v205, v55, v205
    v_xor_b32 v206, v55, v206
    v_xor_b32 v207, v55, v207
    v_or3_b32 v36, v192, v193, v194
    v_or3_b32 v36, v36, v195, v196
    v_or3_b32 v36, v36, v197, v198
    v_or3_b32 v36, v36, v199, v200
    v_or3_b32 v36, v36, v201, v202
    v_or3_b32 v36, v36, v203, v204
    v_or3_b32 v36, v36, v205, v206
    v_or_b32 v36, v36, v207
    v_and_b32 v37, 0x1ff, v36
    v_cmp_ne_u32 vcc, 0, v37
    s_cbranch_vccz L_qok
    s_sub_u32 s15, s15, 1
    s_cbranch_scc1 L_qok
    s_cmp_lg_u32 s15, 199996
    s_cbranch_scc1 L_qagain
    s_mov_b32 s26, 0
L_repub:
    s_mov_b32 s10, 4000000
L_repubw:
    ds_read_b32 v37, v54 offset:18052
    s_waitcnt lgkmcnt(0)
    v_readfirstlane_b32 s9, v37
    s_cmp_lg_u32 s9, 0
    s_cbranch_scc1 L_repubgo
    s_sub_u32 s10, s10, 1
    s_cbranch_scc0 L_repubw
L_repubgo:
    ds_read_b128 v[40:43], v15 offset:18432
    s_waitcnt lgkmcnt(0)
    buffer_store_dwordx4 v[40:43], v10, s[44:47], 0 offen sc1
    s_mov_b32 s27, 1
    s_cmp_eq_u32 s26, 1
    s_cbranch_scc1 L_qok2
L_qagain:
    buffer_load_dwordx4 v[192:195], v9, s[44:47], 0 offen offset:0 sc1
    buffer_load_dwordx4 v[196:199], v9, s[44:47], 0 offen offset:1024 sc1
    buffer_load_dwordx4 v[200:203], v9, s[44:47], 0 offen offset:2048 sc1
    buffer_load_dwordx4 v[204:207], v9, s[44:47], 0 offen offset:3072 sc1
    s_waitcnt vmcnt(0)
    s_branch L_qchk
L_qok:
    v_and_b32 v37, 0xe00, v36
    v_cmp_ne_u32 vcc, 0, v37
    s_nop 0
    s_cmp_eq_u64 vcc, 0
    s_cselect_b32 s5, 3, 1
    s_cbranch_scc1 L_qok2
    s_cmp_eq_u32 s27, 1
    s_cbranch_scc1 L_qok2
    s_mov_b32 s26, 1
    s_branch L_repub
L_qok2:
    v_pk_add_f32 v[192:193], v[192:193], v[196:197]
    v_pk_add_f32 v[194:195], v[194:195], v[198:199]
    v_pk_add_f32 v[200:201], v[200:201], v[204:205]
    v_pk_add_f32 v[202:203], v[202:203], v[206:207]
    v_pk_add_f32 v[192:193], v[192:193], v[200:201]
    v_pk_add_f32 v[194:195], v[194:195], v[202:203]
    v_mov_b32 v40, s5
    v_cvt_pk_bf16_f32 v38, v192, v193
    v_cvt_pk_bf16_f32 v39, v194, v195
    ds_write_b16 v61, v38 offset:16384
    ds_write_b16_d16_hi v61, v38 offset:16400
    ds_write_b16 v61, v39 offset:16416
    ds_write_b16_d16_hi v61, v39 offset:16432
    s_waitcnt lgkmcnt(0)
    ds_write_b32 v54, v40 offset:18064
    s_branch L_kjoin
L_kplain:
    s_waitcnt vmcnt(3)
    buffer_load_dwordx4 v[108:111], v1, s[28:31], s56 offen offset:3072 nt
    s_waitcnt vmcnt(3)
    buffer_load_dwordx4 v[112:115], v1, s[28:31], s57 offen offset:0 nt
    s_waitcnt vmcnt(3)
    buffer_load_dwordx4 v[116:119], v1, s[28:31], s57 offen offset:1024 nt
    s_waitcnt vmcnt(3)
    buffer_load_dwordx4 v[120:123], v1, s[28:31], s57 offen offset:2048 nt
    s_waitcnt vmcnt(3)
    buffer_load_dwordx4 v[124:127], v1, s[28:31], s57 offen offset:3072 nt
L_kjoin:
    s_waitcnt vmcnt(3)
    buffer_load_dwordx4 v[128:131], v2, s[32:35], s21 offen offset:0 nt
    s_waitcnt vmcnt(3)
    buffer_load_dwordx4 v[132:135], v2, s[32:35], s21 offen offset:1024 nt
    s_waitcnt vmcnt(3)
    buffer_load_dwordx4 v[136:139], v2, s[32:35], s21 offen offset:2048 nt
    s_waitcnt vmcnt(3)
    buffer_load_dwordx4 v[140:143], v2, s[32:35], s21 offen offset:3072 nt
    buffer_load_dwordx4 v[144:147], v2, s[32:35], s23 offen offset:0 nt
    buffer_load_dwordx4 v[148:151], v2, s[32:35], s23 offen offset:1024 nt
    s_mov_b32 s15, 4000000
L_qwait:
    ds_read_b32 v36, v54 offset:18064
    ds_read_b128 v[28:31], v62 offset:16384
    s_waitcnt lgkmcnt(0)
    v_readfirstlane_b32 s5, v36
    s_cmp_lg_u32 s5, 0
    s_cbranch_scc1 L_qgo
    s_sub_u32 s15, s15, 1
    s_cbranch_scc0 L_qwait
L_qgo:
    v_mfma_f32_16x16x32_bf16 v[64:67], v[64:67], v[28:31], 0
    v_mfma_f32_16x16x32_bf16 v[68:71], v[68:71], v[28:31], 0
    v_mfma_f32_16x16x32_bf16 v[72:75], v[72:75], v[28:31], 0
    v_mfma_f32_16x16x32_bf16 v[76:79], v[76:79], v[28:31], 0
    v_mfma_f32_16x16x32_bf16 v[80:83], v[80:83], v[28:31], 0
    v_mfma_f32_16x16x32_bf16 v[84:87], v[84:87], v[28:31], 0
    v_mfma_f32_16x16x32_bf16 v[88:91], v[88:91], v[28:31], 0
    v_mfma_f32_16x16x32_bf16 v[92:95], v[92:95], v[28:31], 0
    s_nop 0
    v_mov_b32_dpp v32, v64 quad_perm:[0,1,2,3] row_mask:0xf bank_mask:0x1
    v_mov_b32_dpp v32, v68 row_ror:4 row_mask:0xf bank_mask:0x2
    v_mov_b32_dpp v32, v72 row_ror:8 row_mask:0xf bank_mask:0x4
    v_mov_b32_dpp v32, v76 row_ror:12 row_mask:0xf bank_mask:0x8
    v_add_f32_dpp v32, v65, v32 row_ror:12 row_mask:0xf bank_mask:0x1
    v_add_f32_dpp v32, v69, v32 quad_perm:[0,1,2,3] row_mask:0xf bank_mask:0x2
    v_add_f32_dpp v32, v73, v32 row_ror:4 row_mask:0xf bank_mask:0x4
    v_add_f32_dpp v32, v77, v32 row_ror:8 row_mask:0xf bank_mask:0x8
    v_add_f32_dpp v32, v66, v32 row_ror:8 row_mask:0xf bank_mask:0x1
    v_add_f32_dpp v32, v70, v32 row_ror:12 row_mask:0xf bank_mask:0x2
    v_add_f32_dpp v32, v74, v32 quad_perm:[0,1,2,3] row_mask:0xf bank_mask:0x4
    v_add_f32_dpp v32, v78, v32 row_ror:4 row_mask:0xf bank_mask:0x8
    v_add_f32_dpp v32, v67, v32 row_ror:4 row_mask:0xf bank_mask:0x1
    v_add_f32_dpp v32, v71, v32 row_ror:8 row_mask:0xf bank_mask:0x2
    v_add_f32_dpp v32, v75, v32 row_ror:12 row_mask:0xf bank_mask:0x4
    v_add_f32_dpp v32, v79, v32 quad_perm:[0,1,2,3] row_mask:0xf bank_mask:0x8
    v_mfma_f32_16x16x32_bf16 v[96:99], v[96:99], v[28:31], 0
    v_mfma_f32_16x16x32_bf16 v[100:103], v[100:103], v[28:31], 0
    v_mfma_f32_16x16x32_bf16 v[104:107], v[104:107], v[28:31], 0
    v_mfma_f32_16x16x32_bf16 v[108:111], v[108:111], v[28:31], 0
    v_mov_b32_dpp v33, v80 quad_perm:[0,1,2,3] row_mask:0xf bank_mask:0x1
    v_mov_b32_dpp v33, v84 row_ror:4 row_mask:0xf bank_mask:0x2
    v_mov_b32_dpp v33, v88 row_ror:8 row_mask:0xf bank_mask:0x4
    v_mov_b32_dpp v33, v92 row_ror:12 row_mask:0xf bank_mask:0x8
    v_add_f32_dpp v33, v81, v33 row_ror:12 row_mask:0xf bank_mask:0x1
    v_add_f32_dpp v33, v85, v33 quad_perm:[0,1,2,3] row_mask:0xf bank_mask:0x2
    v_add_f32_dpp v33, v89, v33 row_ror:4 row_mask:0xf bank_mask:0x4
    v_add_f32_dpp v33, v93, v33 row_ror:8 row_mask:0xf bank_mask:0x8
    v_add_f32_dpp v33, v82, v33 row_ror:8 row_mask:0xf bank_mask:0x1
    v_add_f32_dpp v33, v86, v33 row_ror:12 row_mask:0xf bank_mask:0x2
    v_add_f32_dpp v33, v90, v33 quad_perm:[0,1,2,3] row_mask:0xf bank_mask:0x4
    v_add_f32_dpp v33, v94, v33 row_ror:4 row_mask:0xf bank_mask:0x8
    v_add_f32_dpp v33, v83, v33 row_ror:4 row_mask:0xf bank_mask:0x1
    v_add_f32_dpp v33, v87, v33 row_ror:8 row_mask:0xf bank_mask:0x2
    v_add_f32_dpp v33, v91, v33 row_ror:12 row_mask:0xf bank_mask:0x4
    v_add_f32_dpp v33, v95, v33 quad_perm:[0,1,2,3] row_mask:0xf bank_mask:0x8
    v_mfma_f32_16x16x32_bf16 v[112:115], v[112:115], v[28:31], 0
    v_mfma_f32_16x16x32_bf16 v[116:119], v[116:119], v[28:31], 0
    v_mfma_f32_16x16x32_bf16 v[120:123], v[120:123], v[28:31], 0
    v_mfma_f32_16x16x32_bf16 v[124:127], v[124:127], v[28:31], 0
    v_mov_b32_dpp v34, v96 quad_perm:[0,1,2,3] row_mask:0xf bank_mask:0x1
    v_mov_b32_dpp v34, v100 row_ror:4 row_mask:0xf bank_mask:0x2
    v_mov_b32_dpp v34, v104 row_ror:8 row_mask:0xf bank_mask:0x4
    v_mov_b32_dpp v34, v108 row_ror:12 row_mask:0xf bank_mask:0x8
    v_add_f32_dpp v34, v97, v34 row_ror:12 row_mask:0xf bank_mask:0x1
    v_add_f32_dpp v34, v101, v34 quad_perm:[0,1,2,3] row_mask:0xf bank_mask:0x2
    v_add_f32_dpp v34, v105, v34 row_ror:4 row_mask:0xf bank_mask:0x4
    v_add_f32_dpp v34, v109, v34 row_ror:8 row_mask:0xf bank_mask:0x8
    v_add_f32_dpp v34, v98, v34 row_ror:8 row_mask:0xf bank_mask:0x1
    v_add_f32_dpp v34, v102, v34 row_ror:12 row_mask:0xf bank_mask:0x2
    v_add_f32_dpp v34, v106, v34 quad_perm:[0,1,2,3] row_mask:0xf bank_mask:0x4
    v_add_f32_dpp v34, v110, v34 row_ror:4 row_mask:0xf bank_mask:0x8
    v_add_f32_dpp v34, v99, v34 row_ror:4 row_mask:0xf bank_mask:0x1
    v_add_f32_dpp v34, v103, v34 row_ror:8 row_mask:0xf bank_mask:0x2
    v_add_f32_dpp v34, v107, v34 row_ror:12 row_mask:0xf bank_mask:0x4
    v_add_f32_dpp v34, v111, v34 quad_perm:[0,1,2,3] row_mask:0xf bank_mask:0x8
    v_mov_b32_dpp v35, v112 quad_perm:[0,1,2,3] row_mask:0xf bank_mask:0x1
    v_mov_b32_dpp v35, v116 row_ror:4 row_mask:0xf bank_mask:0x2
    v_mov_b32_dpp v35, v120 row_ror:8 row_mask:0xf bank_mask:0x4
    v_mov_b32_dpp v35, v124 row_ror:12 row_mask:0xf bank_mask:0x8
    v_add_f32_dpp v35, v113, v35 row_ror:12 row_mask:0xf bank_mask:0x1
    v_add_f32_dpp v35, v117, v35 quad_perm:[0,1,2,3] row_mask:0xf bank_mask:0x2
    v_add_f32_dpp v35, v121, v35 row_ror:4 row_mask:0xf bank_mask:0x4
    v_add_f32_dpp v35, v125, v35 row_ror:8 row_mask:0xf bank_mask:0x8
    v_add_f32_dpp v35, v114, v35 row_ror:8 row_mask:0xf bank_mask:0x1
    v_add_f32_dpp v35, v118, v35 row_ror:12 row_mask:0xf bank_mask:0x2
    v_add_f32_dpp v35, v122, v35 quad_perm:[0,1,2,3] row_mask:0xf bank_mask:0x4
    v_add_f32_dpp v35, v126, v35 row_ror:4 row_mask:0xf bank_mask:0x8
    v_add_f32_dpp v35, v115, v35 row_ror:4 row_mask:0xf bank_mask:0x1
    v_add_f32_dpp v35, v119, v35 row_ror:8 row_mask:0xf bank_mask:0x2
    v_add_f32_dpp v35, v123, v35 row_ror:12 row_mask:0xf bank_mask:0x4
    v_add_f32_dpp v35, v127, v35 quad_perm:[0,1,2,3] row_mask:0xf bank_mask:0x8
    v_max3_f32 v57, v32, v33, v34
    v_max_f32 v57, v57, v35
    s_nop 1
    v_max_f32_dpp v57, v57, v57 row_ror:4 row_mask:0xf bank_mask:0xf
    s_nop 1
    v_max_f32_dpp v57, v57, v57 row_ror:8 row_mask:0xf bank_mask:0xf
    v_mov_b32 v37, v57
    s_nop 1
    v_permlane16_swap_b32 v57, v37
    v_max_f32 v57, v57, v37
    v_mov_b32 v37, v57
    s_nop 1
    v_permlane32_swap_b32 v57, v37
    v_max_f32 v57, v57, v37
    v_mul_f32 v57, s17, v57
    v_fma_f32 v32, v32, s17, -v57
    v_fma_f32 v33, v33, s17, -v57
    v_fma_f32 v34, v34, s17, -v57
    v_fma_f32 v35, v35, s17, -v57
    ds_write_b32 v244, v57 offset:16896
    v_exp_f32 v32, v32
    v_exp_f32 v33, v33
    v_exp_f32 v34, v34
    v_exp_f32 v35, v35
    v_add_f32 v56, v32, v33
    v_add_f32 v37, v34, v35
    v_cvt_pk_bf16_f32 v32, v32, v32
    v_cvt_pk_bf16_f32 v33, v33, v33
    v_cvt_pk_bf16_f32 v34, v34, v34
    v_cvt_pk_bf16_f32 v35, v35, v35
    v_add_f32 v56, v56, v37
    v_and_b32 v32, v8, v32
    v_and_b32 v33, v8, v33
    v_and_b32 v34, v8, v34
    v_and_b32 v35, v8, v35
    v_mov_b32_dpp v16, v32 quad_perm:[0,1,2,3] row_mask:0xf bank_mask:0x1
    v_mov_b32_dpp v17, v32 row_ror:4 row_mask:0xf bank_mask:0x2
    v_mov_b32_dpp v18, v32 row_ror:8 row_mask:0xf bank_mask:0x4
    v_mov_b32_dpp v19, v32 row_ror:12 row_mask:0xf bank_mask:0x8
    s_waitcnt vmcnt(5)
    s_nop 0
    v_mfma_f32_16x16x32_bf16 v[24:27], v[128:131], v[16:19], 0
    v_mov_b32_dpp v20, v32 row_ror:12 row_mask:0xf bank_mask:0x1
    v_mov_b32_dpp v21, v32 quad_perm:[0,1,2,3] row_mask:0xf bank_mask:0x2
    v_mov_b32_dpp v22, v32 row_ror:4 row_mask:0xf bank_mask:0x4
    v_mov_b32_dpp v23, v32 row_ror:8 row_mask:0xf bank_mask:0x8
    s_waitcnt vmcnt(4)
    s_nop 0
    v_mfma_f32_16x16x32_bf16 v[24:27], v[132:135], v[20:23], v[24:27]
    v_mov_b32_dpp v16, v32 row_ror:8 row_mask:0xf bank_mask:0x1
    v_mov_b32_dpp v17, v32 row_ror:12 row_mask:0xf bank_mask:0x2
    v_mov_b32_dpp v18, v32 quad_perm:[0,1,2,3] row_mask:0xf bank_mask:0x4
    v_mov_b32_dpp v19, v32 row_ror:4 row_mask:0xf bank_mask:0x8
    v_add_f32_dpp v56, v56, v56 row_ror:4 row_mask:0xf bank_mask:0xf
    s_nop 1
    v_add_f32_dpp v56, v56, v56 row_ror:8 row_mask:0xf bank_mask:0xf
    v_mov_b32 v37, v56
    s_nop 1
    v_permlane16_swap_b32 v56, v37
    v_add_f32 v56, v56, v37
    v_mov_b32 v37, v56
    s_nop 1
    v_permlane32_swap_b32 v56, v37
    v_add_f32 v56, v56, v37
    s_waitcnt vmcnt(3)
    v_mfma_f32_16x16x32_bf16 v[24:27], v[136:139], v[16:19], v[24:27]
    buffer_load_dwordx4 v[152:155], v2, s[32:35], s23 offen offset:2048 nt
    v_mov_b32_dpp v20, v32 row_ror:4 row_mask:0xf bank_mask:0x1
    v_mov_b32_dpp v21, v32 row_ror:8 row_mask:0xf bank_mask:0x2
    v_mov_b32_dpp v22, v32 row_ror:12 row_mask:0xf bank_mask:0x4
    v_mov_b32_dpp v23, v32 quad_perm:[0,1,2,3] row_mask:0xf bank_mask:0x8
    s_waitcnt vmcnt(3)
    s_nop 0
    v_mfma_f32_16x16x32_bf16 v[24:27], v[140:143], v[20:23], v[24:27]
    buffer_load_dwordx4 v[156:159], v2, s[32:35], s23 offen offset:3072 nt
    v_mov_b32_dpp v16, v33 quad_perm:[0,1,2,3] row_mask:0xf bank_mask:0x1
    v_mov_b32_dpp v17, v33 row_ror:4 row_mask:0xf bank_mask:0x2
    v_mov_b32_dpp v18, v33 row_ror:8 row_mask:0xf bank_mask:0x4
    v_mov_b32_dpp v19, v33 row_ror:12 row_mask:0xf bank_mask:0x8
    s_waitcnt vmcnt(3)
    s_nop 0
    v_mfma_f32_16x16x32_bf16 v[24:27], v[144:147], v[16:19], v[24:27]
    buffer_load_dwordx4 v[160:163], v2, s[32:35], s56 offen offset:0 nt
    v_mov_b32_dpp v20, v33 row_ror:12 row_mask:0xf bank_mask:0x1
    v_mov_b32_dpp v21, v33 quad_perm:[0,1,2,3] row_mask:0xf bank_mask:0x2
    v_mov_b32_dpp v22, v33 row_ror:4 row_mask:0xf bank_mask:0x4
    v_mov_b32_dpp v23, v33 row_ror:8 row_mask:0xf bank_mask:0x8
    s_waitcnt vmcnt(3)
    s_nop 0
    v_mfma_f32_16x16x32_bf16 v[24:27], v[148:151], v[20:23], v[24:27]
    buffer_load_dwordx4 v[164:167], v2, s[32:35], s56 offen offset:1024 nt
    v_mov_b32_dpp v16, v33 row_ror:8 row_mask:0xf bank_mask:0x1
    v_mov_b32_dpp v17, v33 row_ror:12 row_mask:0xf bank_mask:0x2
    v_mov_b32_dpp v18, v33 quad_perm:[0,1,2,3] row_mask:0xf bank_mask:0x4
    v_mov_b32_dpp v19, v33 row_ror:4 row_mask:0xf bank_mask:0x8
    s_waitcnt vmcnt(3)
    s_nop 0
    v_mfma_f32_16x16x32_bf16 v[24:27], v[152:155], v[16:19], v[24:27]
    buffer_load_dwordx4 v[168:171], v2, s[32:35], s56 offen offset:2048 nt
    v_mov_b32_dpp v20, v33 row_ror:4 row_mask:0xf bank_mask:0x1
    v_mov_b32_dpp v21, v33 row_ror:8 row_mask:0xf bank_mask:0x2
    v_mov_b32_dpp v22, v33 row_ror:12 row_mask:0xf bank_mask:0x4
    v_mov_b32_dpp v23, v33 quad_perm:[0,1,2,3] row_mask:0xf bank_mask:0x8
    s_waitcnt vmcnt(3)
    s_nop 0
    v_mfma_f32_16x16x32_bf16 v[24:27], v[156:159], v[20:23], v[24:27]
    buffer_load_dwordx4 v[172:175], v2, s[32:35], s56 offen offset:3072 nt
    v_mov_b32_dpp v16, v34 quad_perm:[0,1,2,3] row_mask:0xf bank_mask:0x1
    v_mov_b32_dpp v17, v34 row_ror:4 row_mask:0xf bank_mask:0x2
    v_mov_b32_dpp v18, v34 row_ror:8 row_mask:0xf bank_mask:0x4
    v_mov_b32_dpp v19, v34 row_ror:12 row_mask:0xf bank_mask:0x8
    s_waitcnt vmcnt(3)
    s_nop 0
    v_mfma_f32_16x16x32_bf16 v[24:27], v[160:163], v[16:19], v[24:27]
    s_mov_b32 m0, s24
    s_nop 0
    buffer_load_dwordx4 v5, s[40:43], 0 offen offset:0 nt lds
    v_mov_b32_dpp v20, v34 row_ror:12 row_mask:0xf bank_mask:0x1
    v_mov_b32_dpp v21, v34 quad_perm:[0,1,2,3] row_mask:0xf bank_mask:0x2
    v_mov_b32_dpp v22, v34 row_ror:4 row_mask:0xf bank_mask:0x4
    v_mov_b32_dpp v23, v34 row_ror:8 row_mask:0xf bank_mask:0x8
    s_waitcnt vmcnt(3)
    s_nop 0
    v_mfma_f32_16x16x32_bf16 v[24:27], v[164:167], v[20:23], v[24:27]
    buffer_load_dwordx4 v[176:179], v2, s[32:35], s57 offen offset:0 nt
    v_mov_b32_dpp v16, v34 row_ror:8 row_mask:0xf bank_mask:0x1
    v_mov_b32_dpp v17, v34 row_ror:12 row_mask:0xf bank_mask:0x2
    v_mov_b32_dpp v18, v34 quad_perm:[0,1,2,3] row_mask:0xf bank_mask:0x4
    v_mov_b32_dpp v19, v34 row_ror:4 row_mask:0xf bank_mask:0x8
    s_waitcnt vmcnt(3)
    s_nop 0
    v_mfma_f32_16x16x32_bf16 v[24:27], v[168:171], v[16:19], v[24:27]
    buffer_load_dwordx4 v[180:183], v2, s[32:35], s57 offen offset:1024 nt
    v_mov_b32_dpp v20, v34 row_ror:4 row_mask:0xf bank_mask:0x1
    v_mov_b32_dpp v21, v34 row_ror:8 row_mask:0xf bank_mask:0x2
    v_mov_b32_dpp v22, v34 row_ror:12 row_mask:0xf bank_mask:0x4
    v_mov_b32_dpp v23, v34 quad_perm:[0,1,2,3] row_mask:0xf bank_mask:0x8
    s_waitcnt vmcnt(3)
    s_nop 0
    v_mfma_f32_16x16x32_bf16 v[24:27], v[172:175], v[20:23], v[24:27]
    buffer_load_dwordx4 v[184:187], v2, s[32:35], s57 offen offset:2048 nt
    v_mov_b32_dpp v16, v35 quad_perm:[0,1,2,3] row_mask:0xf bank_mask:0x1
    v_mov_b32_dpp v17, v35 row_ror:4 row_mask:0xf bank_mask:0x2
    v_mov_b32_dpp v18, v35 row_ror:8 row_mask:0xf bank_mask:0x4
    v_mov_b32_dpp v19, v35 row_ror:12 row_mask:0xf bank_mask:0x8
    s_waitcnt vmcnt(3)
    buffer_load_dwordx4 v[188:191], v2, s[32:35], s57 offen offset:3072 nt
    s_waitcnt vmcnt(3)
    v_mfma_f32_16x16x32_bf16 v[24:27], v[176:179], v[16:19], v[24:27]
    s_mov_b32 m0, s24
    s_nop 0
    buffer_load_dwordx4 v5, s[40:43], 0 offen offset:1024 nt lds
    v_mov_b32_dpp v20, v35 row_ror:12 row_mask:0xf bank_mask:0x1
    v_mov_b32_dpp v21, v35 quad_perm:[0,1,2,3] row_mask:0xf bank_mask:0x2
    v_mov_b32_dpp v22, v35 row_ror:4 row_mask:0xf bank_mask:0x4
    v_mov_b32_dpp v23, v35 row_ror:8 row_mask:0xf bank_mask:0x8
    s_waitcnt vmcnt(3)
    s_nop 0
    v_mfma_f32_16x16x32_bf16 v[24:27], v[180:183], v[20:23], v[24:27]
    s_mov_b32 m0, s24
    s_nop 0
    buffer_load_dwordx4 v5, s[40:43], 0 offen offset:2048 nt lds
    s_mov_b32 m0, s24
    s_nop 0
    buffer_load_dwordx4 v5, s[40:43], 0 offen offset:3072 nt lds
    s_mov_b32 m0, s25
    s_mov_b32 exec_hi, 0
    buffer_load_dwordx4 v3, s[40:43], 0 offen nt lds
    s_mov_b32 exec_hi, -1
    v_mov_b32_dpp v16, v35 row_ror:8 row_mask:0xf bank_mask:0x1
    v_mov_b32_dpp v17, v35 row_ror:12 row_mask:0xf bank_mask:0x2
    v_mov_b32_dpp v18, v35 quad_perm:[0,1,2,3] row_mask:0xf bank_mask:0x4
    v_mov_b32_dpp v19, v35 row_ror:4 row_mask:0xf bank_mask:0x8
    s_waitcnt lgkmcnt(0)
    s_barrier
    s_cmp_lg_u32 s3, 5
    s_cbranch_scc1 L_notouch
    s_mov_b64 exec, 0xffff
    buffer_load_dword v240, v11, s[44:47], 0 offen sc1
    s_mov_b64 exec, -1
L_notouch:
    ds_read_b128 v[36:39], v63 offset:16896
    ds_read_b128 v[40:43], v63 offset:16912
    s_waitcnt lgkmcnt(0)
    v_max3_f32 v36, v36, v37, v38
    v_max3_f32 v39, v39, v40, v41
    v_max3_f32 v36, v36, v42, v43
    v_max_f32 v36, v36, v39
    v_and_b32 v36, s16, v36
    v_sub_f32 v59, v57, v36
    v_exp_f32 v59, v59
    v_mov_b32_dpp v58, v36 quad_perm:[0,0,0,0] row_mask:0xf bank_mask:0xf
    v_mov_b32_dpp v38, v36 quad_perm:[2,2,2,2] row_mask:0xf bank_mask:0xf
    v_mul_f32 v56, v59, v56
    s_cmp_eq_u32 s22, 1
    s_cselect_b64 vcc, -1, 0
    ds_write_b32 v244, v56 offset:16960
    v_cndmask_b32 v58, v58, v38, vcc
    v_or_b32 v58, v14, v58
    s_waitcnt vmcnt(5)
    v_mfma_f32_16x16x32_bf16 v[24:27], v[184:187], v[16:19], v[24:27]
    v_mov_b32_dpp v20, v35 row_ror:4 row_mask:0xf bank_mask:0x1
    v_mov_b32_dpp v21, v35 row_ror:8 row_mask:0xf bank_mask:0x2
    v_mov_b32_dpp v22, v35 row_ror:12 row_mask:0xf bank_mask:0x4
    v_mov_b32_dpp v23, v35 quad_perm:[0,1,2,3] row_mask:0xf bank_mask:0x8
    s_waitcnt vmcnt(4)
    s_nop 0
    v_mfma_f32_16x16x32_bf16 v[24:27], v[188:191], v[20:23], v[24:27]
    s_nop 7
    v_mul_f32 v24, v59, v24
    v_mul_f32 v25, v59, v25
    v_mul_f32 v26, v59, v26
    v_mul_f32 v27, v59, v27
    ds_write_b128 v60, v[24:27] offset:8192
    s_waitcnt lgkmcnt(0)
    s_barrier
    s_cmp_lt_u32 s3, 6
    s_cbranch_scc1 L_nopub
    ds_read_b64 v[208:209], v245 offset:8192
    ds_read_b64 v[210:211], v245 offset:9216
    ds_read_b64 v[212:213], v245 offset:10240
    ds_read_b64 v[214:215], v245 offset:11264
    ds_read_b64 v[216:217], v245 offset:12288
    ds_read_b64 v[218:219], v245 offset:13312
    ds_read_b64 v[220:221], v245 offset:14336
    ds_read_b64 v[222:223], v245 offset:15360
    ds_read_b128 v[40:43], v247 offset:16960
    ds_read_b128 v[44:47], v247 offset:16976
    s_waitcnt lgkmcnt(2)
    v_pk_add_f32 v[208:209], v[208:209], v[210:211]
    v_pk_add_f32 v[212:213], v[212:213], v[214:215]
    v_pk_add_f32 v[216:217], v[216:217], v[218:219]
    v_pk_add_f32 v[220:221], v[220:221], v[222:223]
    v_pk_add_f32 v[208:209], v[208:209], v[212:213]
    v_pk_add_f32 v[216:217], v[216:217], v[220:221]
    v_pk_add_f32 v[208:209], v[208:209], v[216:217]
    s_waitcnt lgkmcnt(0)
    v_pk_add_f32 v[40:41], v[40:41], v[44:45]
    v_pk_add_f32 v[42:43], v[42:43], v[46:47]
    v_and_or_b32 v36, v208, s16, v14
    v_pk_add_f32 v[40:41], v[40:41], v[42:43]
    v_and_or_b32 v37, v209, s16, v14
    v_mov_b32 v38, v58
    v_add_f32 v40, v40, v41
    v_and_or_b32 v39, v40, s16, v14
    s_cmp_eq_u32 s5, 3
    s_cbranch_scc1 L_pubfast
    buffer_store_dwordx4 v[36:39], v246, s[44:47], 0 offen sc1
    s_branch L_pubdone
L_pubfast:
    buffer_store_dwordx4 v[36:39], v246, s[44:47], 0 offen
L_pubdone:
    s_waitcnt vmcnt(1)
    s_branch L_barA2
L_nopub:
    s_waitcnt vmcnt(0)
L_barA2:
    s_barrier
    s_cmp_eq_u32 s3, 5
    s_cbranch_scc1 L_gatherA
    s_cmp_gt_u32 s3, 5
    s_cbranch_scc1 L_barB
    ds_read_b128 v[64:67], v4 offset:19456
    ds_read_b128 v[68:71], v4 offset:24064
    ds_read_b128 v[72:75], v4 offset:37888
    ds_read_b128 v[76:79], v4 offset:42496
    ds_read_b128 v[80:83], v4 offset:28672
    ds_read_b128 v[84:87], v4 offset:33280
    ds_read_b128 v[88:91], v4 offset:47104
    ds_read_b128 v[92:95], v4 offset:51712
    s_branch L_barB
L_gatherA:
    s_mov_b32 s15, 200000
    s_movk_i32 s20, 0x1000
L_pollA:
    s_cmp_eq_u32 s5, 3
    s_cbranch_scc1 L_pollAf
    buffer_load_dwordx4 v[192:195], v248, s[44:47], 0 offen sc1
    buffer_load_dwordx4 v[196:199], v248, s[44:47], s20 offen sc1
    s_branch L_pollAw
L_pollAf:
    buffer_load_dwordx4 v[192:195], v248, s[44:47], 0 offen nt
    buffer_load_dwordx4 v[196:199], v248, s[44:47], s20 offen nt
L_pollAw:
    s_waitcnt vmcnt(0)
    v_xor_b32 v192, v14, v192
    v_xor_b32 v193, v14, v193
    v_xor_b32 v194, v14, v194
    v_xor_b32 v195, v14, v195
    v_xor_b32 v196, v14, v196
    v_xor_b32 v197, v14, v197
    v_xor_b32 v198, v14, v198
    v_xor_b32 v199, v14, v199
    v_or3_b32 v36, v192, v193, v194
    v_or3_b32 v37, v195, v196, v197
    v_or3_b32 v36, v36, v198, v199
    v_or_b32 v36, v36, v37
    v_and_b32 v36, 0xfff, v36
    v_cmp_ne_u32 vcc, 0, v36
    s_cbranch_vccz L_okA
    s_mov_b64 exec, vcc
    s_sub_u32 s15, s15, 1
    s_cbranch_scc0 L_pollA
L_okA:
    s_mov_b64 exec, -1
    v_max_f32 v36, v194, v198
    s_nop 1
    v_max_f32_dpp v36, v36, v36 quad_perm:[1,0,3,2] row_mask:0xf bank_mask:0xf
    v_sub_f32 v194, v194, v36
    v_sub_f32 v198, v198, v36
    v_exp_f32 v194, v194
    v_exp_f32 v198, v198
    v_mul_f32 v195, v194, v195
    v_mul_f32 v192, v194, v192
    v_mul_f32 v193, v194, v193
    v_fmac_f32 v195, v198, v199
    v_fmac_f32 v192, v198, v196
    v_fmac_f32 v193, v198, v197
    v_add_f32_dpp v195, v195, v195 quad_perm:[1,0,3,2] row_mask:0xf bank_mask:0xf
    v_add_f32_dpp v192, v192, v192 quad_perm:[1,0,3,2] row_mask:0xf bank_mask:0xf
    v_add_f32_dpp v193, v193, v193 quad_perm:[1,0,3,2] row_mask:0xf bank_mask:0xf
    v_rcp_f32 v195, v195
    s_nop 0
    v_mul_f32 v192, v195, v192
    v_mul_f32 v193, v195, v193
    v_cvt_pk_bf16_f32 v36, v192, v192
    v_cvt_pk_bf16_f32 v37, v193, v193
    v_and_b32 v36, v8, v36
    v_and_b32 v37, v8, v37
    ds_write_b64 v249, v[36:37] offset:17024
    s_waitcnt lgkmcnt(0)
L_barB:
    s_barrier
    s_cmp_ge_u32 s3, 5
    s_cbranch_scc1 L_phase4
    ds_read_b64 v[32:33], v249 offset:17024
    s_waitcnt lgkmcnt(0)
    v_mov_b32_dpp v16, v32 quad_perm:[0,1,2,3] row_mask:0xf bank_mask:0x1
    v_mov_b32_dpp v17, v32 row_ror:4 row_mask:0xf bank_mask:0x2
    v_mov_b32_dpp v18, v32 row_ror:8 row_mask:0xf bank_mask:0x4
    v_mov_b32_dpp v19, v32 row_ror:12 row_mask:0xf bank_mask:0x8
    v_mov_b32_dpp v20, v32 row_ror:12 row_mask:0xf bank_mask:0x1
    v_mov_b32_dpp v21, v32 quad_perm:[0,1,2,3] row_mask:0xf bank_mask:0x2
    v_mov_b32_dpp v22, v32 row_ror:4 row_mask:0xf bank_mask:0x4
    v_mov_b32_dpp v23, v32 row_ror:8 row_mask:0xf bank_mask:0x8
    v_mfma_f32_16x16x32_bf16 v[24:27], v[64:67], v[16:19], 0
    v_mov_b32_dpp v16, v32 row_ror:8 row_mask:0xf bank_mask:0x1
    v_mov_b32_dpp v17, v32 row_ror:12 row_mask:0xf bank_mask:0x2
    v_mov_b32_dpp v18, v32 quad_perm:[0,1,2,3] row_mask:0xf bank_mask:0x4
    v_mov_b32_dpp v19, v32 row_ror:4 row_mask:0xf bank_mask:0x8
    v_mfma_f32_16x16x32_bf16 v[24:27], v[68:71], v[20:23], v[24:27]
    v_mov_b32_dpp v20, v32 row_ror:4 row_mask:0xf bank_mask:0x1
    v_mov_b32_dpp v21, v32 row_ror:8 row_mask:0xf bank_mask:0x2
    v_mov_b32_dpp v22, v32 row_ror:12 row_mask:0xf bank_mask:0x4
    v_mov_b32_dpp v23, v32 quad_perm:[0,1,2,3] row_mask:0xf bank_mask:0x8
    v_mfma_f32_16x16x32_bf16 v[24:27], v[72:75], v[16:19], v[24:27]
    v_mov_b32_dpp v16, v33 quad_perm:[0,1,2,3] row_mask:0xf bank_mask:0x1
    v_mov_b32_dpp v17, v33 row_ror:4 row_mask:0xf bank_mask:0x2
    v_mov_b32_dpp v18, v33 row_ror:8 row_mask:0xf bank_mask:0x4
    v_mov_b32_dpp v19, v33 row_ror:12 row_mask:0xf bank_mask:0x8
    v_mfma_f32_16x16x32_bf16 v[24:27], v[76:79], v[20:23], v[24:27]
    v_mov_b32_dpp v20, v33 row_ror:12 row_mask:0xf bank_mask:0x1
    v_mov_b32_dpp v21, v33 quad_perm:[0,1,2,3] row_mask:0xf bank_mask:0x2
    v_mov_b32_dpp v22, v33 row_ror:4 row_mask:0xf bank_mask:0x4
    v_mov_b32_dpp v23, v33 row_ror:8 row_mask:0xf bank_mask:0x8
    v_mfma_f32_16x16x32_bf16 v[24:27], v[80:83], v[16:19], v[24:27]
    v_mov_b32_dpp v16, v33 row_ror:8 row_mask:0xf bank_mask:0x1
    v_mov_b32_dpp v17, v33 row_ror:12 row_mask:0xf bank_mask:0x2
    v_mov_b32_dpp v18, v33 quad_perm:[0,1,2,3] row_mask:0xf bank_mask:0x4
    v_mov_b32_dpp v19, v33 row_ror:4 row_mask:0xf bank_mask:0x8
    v_mfma_f32_16x16x32_bf16 v[24:27], v[84:87], v[20:23], v[24:27]
    v_mov_b32_dpp v20, v33 row_ror:4 row_mask:0xf bank_mask:0x1
    v_mov_b32_dpp v21, v33 row_ror:8 row_mask:0xf bank_mask:0x2
    v_mov_b32_dpp v22, v33 row_ror:12 row_mask:0xf bank_mask:0x4
    v_mov_b32_dpp v23, v33 quad_perm:[0,1,2,3] row_mask:0xf bank_mask:0x8
    v_mfma_f32_16x16x32_bf16 v[24:27], v[88:91], v[16:19], v[24:27]
    s_nop 0
    v_mfma_f32_16x16x32_bf16 v[24:27], v[92:95], v[20:23], v[24:27]
    s_nop 7
    v_and_or_b32 v36, v24, s16, v14
    v_and_or_b32 v37, v25, s16, v14
    v_and_or_b32 v38, v26, s16, v14
    v_and_or_b32 v39, v27, s16, v14
    s_cmp_eq_u32 s3, 4
    s_cselect_b32 exec_hi, 0, -1
    buffer_store_dwordx4 v[36:39], v250, s[44:47], 0 offen sc1
    s_mov_b32 exec_hi, -1
L_phase4:
    s_cmp_ge_u32 s18, 72
    s_cbranch_scc1 L_exit
    s_waitcnt vmcnt(0)
    s_barrier
    s_mov_b32 s15, 200000
L_pollB:
    buffer_load_dwordx4 v[192:195], v251, s[44:47], 0 offen sc1
    s_waitcnt vmcnt(0)
    v_xor_b32 v192, v14, v192
    v_xor_b32 v193, v14, v193
    v_xor_b32 v194, v14, v194
    v_xor_b32 v195, v14, v195
    v_or3_b32 v40, v192, v193, v194
    v_or_b32 v40, v40, v195
    v_and_b32 v40, 0xfff, v40
    v_cmp_ne_u32 vcc, 0, v40
    s_cbranch_vccz L_okB
    s_mov_b64 exec, vcc
    s_sub_u32 s15, s15, 1
    s_cbranch_scc0 L_pollB
L_okB:
    s_mov_b64 exec, -1
    v_permlane32_swap_b32 v192, v193
    v_permlane32_swap_b32 v194, v195
    v_add_f32 v192, v192, v193
    v_add_f32 v194, v194, v195
    s_nop 1
    v_permlane16_swap_b32 v192, v194
    v_add_f32 v192, v192, v194
    s_nop 1
    v_add_f32_dpp v192, v192, v192 row_ror:4 row_mask:0xf bank_mask:0xf
    s_nop 1
    v_add_f32_dpp v192, v192, v192 row_ror:8 row_mask:0xf bank_mask:0xf
    ds_write_b32 v252, v192 offset:17536
    s_waitcnt lgkmcnt(0)
    s_barrier
    s_cmp_lg_u32 s3, 0
    s_cbranch_scc1 L_exit
    ds_read_b32 v192, v253 offset:17536
    ds_read_b32 v193, v253 offset:17792
    s_waitcnt lgkmcnt(0)
    v_add_f32 v192, v192, v193
    s_nop 1
    v_add_f32_dpp v192, v192, v192 row_ror:4 row_mask:0xf bank_mask:0xf
    s_nop 1
    v_add_f32_dpp v192, v192, v192 row_ror:8 row_mask:0xf bank_mask:0xf
    v_cvt_pk_bf16_f32 v192, v192, v192
    s_mov_b32 exec_lo, 0x000f000f
    s_mov_b32 exec_hi, 0x000f000f
    buffer_store_short v192, v254, s[48:51], 0 offen
    s_cmp_lg_u32 s18, 0
    s_cbranch_scc1 L_exit
    s_mov_b64 exec, 1
    buffer_store_dword v14, v255, s[44:47], 0 offen sc1
L_exit:
L_end:
    s_endpgm
L_codeend:
.section .rodata,"a"
.p2align 6
.amdhsa_kernel concat_heads__sliding_block_cached__sliding_block_cached__decode_kernel
  .amdhsa_next_free_vgpr 256
  .amdhsa_next_free_sgpr 102
  .amdhsa_accum_offset 256
  .amdhsa_group_segment_fixed_size 0
  .amdhsa_kernarg_size 104
  .amdhsa_user_sgpr_count 2
  .amdhsa_user_sgpr_kernarg_segment_ptr 1
  .amdhsa_system_sgpr_workgroup_id_x 1
.end_amdhsa_kernel
```
